```python
import torch

def _softmax(x, axis=-1):
    return torch.softmax(x, dim=axis)
def _gelu(x):
    return torch.nn.functional.gelu(x, approximate="tanh")
def _silu(x):
    return torch.nn.functional.silu(x)
def _sigmoid(x):
    return torch.sigmoid(x)
def _layernorm(x, axis=-1, eps=1e-5):
    m = x.mean(dim=axis, keepdim=True)
    v = x.var(dim=axis, keepdim=True, unbiased=False)
    return (x - m) / torch.sqrt(v + eps)
def _scatter_add(tgt, idx, src, axis=0):
    return tgt.clone().index_add_(axis, idx, src)
def _segment_sum(src, seg, n):
    out = torch.zeros((n,) + src.shape[1:], dtype=src.dtype)
    return out.index_add_(0, seg, src)
def _pad(x, pw):
    flat = tuple(v for pair in reversed(pw) for v in pair)
    return torch.nn.functional.pad(x, flat)

kernel_name = 'standalone__low_rank_proj_linformer__sampling'

def setup_inputs():

    _w = (lambda a: (lambda t: t.to(torch.bfloat16) if t.is_floating_point() else t)(torch.as_tensor(a)))
    B, H, Sq, Skv, Dh, R = 16, 32, 32, 4096, 128, 16
    return {
        "q": _w((lambda *s: torch.randn(*s, dtype=torch.bfloat16) * 0.8)(B, H, Sq, Dh)),
        "k": _w((lambda *s: torch.randn(*s, dtype=torch.bfloat16) * 0.8)(B, H, Skv, Dh)),
        "v": _w((lambda *s: torch.randn(*s, dtype=torch.bfloat16) * 0.05)(B, H, Skv, Dh)),
        "e_proj": _w((lambda *s: torch.randn(*s, dtype=torch.bfloat16) * 0.8)(R, Skv) * (Skv ** -0.5)),
        "f_proj": _w((lambda *s: torch.randn(*s, dtype=torch.bfloat16) * 0.05)(R, Skv) * (Skv ** -0.5)),
    }

def reference(q, k, v, e_proj, f_proj):
    B, H, Sq, Dh = q.shape
    kp = torch.einsum("rn,bhnd->bhrd", e_proj, k)
    vp = torch.einsum("rn,bhnd->bhrd", f_proj, v)
    scores = torch.einsum("bhqd,bhrd->bhqr", q, kp) * (Dh ** -0.5)
    p = _softmax(scores, axis=-1)
    o = torch.einsum("bhqr,bhrd->bhqd", p, vp)
    return o
```

```asm
; @launch grid=(256,1,1) block=(128,1,1) lds=98304
.amdgcn_target "amdgcn-amd-amdhsa--gfx950"
.text
.globl standalone__low_rank_proj_linformer__sampling_kernel
.p2align 8
.type standalone__low_rank_proj_linformer__sampling_kernel,@function
standalone__low_rank_proj_linformer__sampling_kernel:
    s_cmp_ge_u32 s2, 256
    s_cbranch_scc1 L_end
    s_load_dwordx8 s[4:11], s[0:1], 0
    s_load_dwordx4 s[12:15], s[0:1], 32
    s_load_dwordx2 s[32:33], s[0:1], 48
    v_lshrrev_b32 v8, 6, v0
    v_and_b32 v9, 15, v0
    v_bfe_u32 v10, v0, 4, 2
    v_readfirstlane_b32 s45, v8
    v_lshlrev_b32 v1, 13, v8
    v_lshl_add_u32 v1, v10, 11, v1
    v_lshl_add_u32 v1, v9, 4, v1
    v_lshlrev_b32 v2, 13, v9
    v_lshl_add_u32 v2, v10, 4, v2
    v_lshl_add_u32 v2, v8, 6, v2
    s_lshl_b32 s3, s2, 21
    s_lshl_b32 s55, s2, 14
    s_mov_b32 s18, 0x200000
    s_mov_b32 s19, 0x20000
    s_mov_b32 s22, 0x20000
    s_mov_b32 s23, 0x20000
    s_mov_b32 s43, 0
    s_mov_b32 s44, 0
    s_mov_b32 s47, 0
    s_waitcnt lgkmcnt(0)
    s_add_u32 s16, s6, s3
    s_addc_u32 s17, s7, 0
    s_mov_b32 s20, s10
    s_mov_b32 s21, s11
    buffer_load_dwordx4 v[120:123], v1, s[16:19], s43 offen nt
    buffer_load_dwordx4 v[124:127], v1, s[16:19], s43 offen offset:256 nt
    buffer_load_dwordx4 v[128:131], v1, s[16:19], s43 offen offset:512 nt
    buffer_load_dwordx4 v[132:135], v1, s[16:19], s43 offen offset:768 nt
    buffer_load_dwordx4 v[136:139], v1, s[16:19], s43 offen offset:1024 nt
    buffer_load_dwordx4 v[140:143], v1, s[16:19], s43 offen offset:1280 nt
    buffer_load_dwordx4 v[144:147], v1, s[16:19], s43 offen offset:1536 nt
    buffer_load_dwordx4 v[148:151], v1, s[16:19], s43 offen offset:1792 nt
    buffer_load_dwordx4 v[152:155], v2, s[20:23], s44 offen
    s_add_u32 s43, s43, 0x4000
    s_add_u32 s44, s44, 128
    s_and_b32 s44, s44, 0x1fff
    s_add_u32 s47, s47, 1
    buffer_load_dwordx4 v[156:159], v1, s[16:19], s43 offen nt
    buffer_load_dwordx4 v[160:163], v1, s[16:19], s43 offen offset:256 nt
    buffer_load_dwordx4 v[164:167], v1, s[16:19], s43 offen offset:512 nt
    buffer_load_dwordx4 v[168:171], v1, s[16:19], s43 offen offset:768 nt
    buffer_load_dwordx4 v[172:175], v1, s[16:19], s43 offen offset:1024 nt
    buffer_load_dwordx4 v[176:179], v1, s[16:19], s43 offen offset:1280 nt
    buffer_load_dwordx4 v[180:183], v1, s[16:19], s43 offen offset:1536 nt
    buffer_load_dwordx4 v[184:187], v1, s[16:19], s43 offen offset:1792 nt
    buffer_load_dwordx4 v[188:191], v2, s[20:23], s44 offen
    s_add_u32 s43, s43, 0x4000
    s_add_u32 s44, s44, 128
    s_and_b32 s44, s44, 0x1fff
    s_add_u32 s47, s47, 1
    s_add_u32 s24, s4, s55
    s_addc_u32 s25, s5, 0
    s_mov_b32 s26, 0x4000
    s_mov_b32 s27, 0x20000
    s_lshl_b32 s53, s45, 13
    v_and_b32 v12, 63, v0
    v_lshlrev_b32 v193, 4, v12
    s_add_u32 s54, s53, 32768
    s_mov_b32 m0, s54
    s_nop 0
    buffer_load_dwordx4 v193, s[24:27], s53 offen nt lds
    buffer_load_dwordx4 v193, s[24:27], s53 offen offset:1024 nt lds
    buffer_load_dwordx4 v193, s[24:27], s53 offen offset:2048 nt lds
    buffer_load_dwordx4 v193, s[24:27], s53 offen offset:3072 nt lds
    s_add_u32 s53, s53, 0x1000
    s_add_u32 s54, s53, 32768
    s_mov_b32 m0, s54
    s_nop 0
    buffer_load_dwordx4 v193, s[24:27], s53 offen nt lds
    buffer_load_dwordx4 v193, s[24:27], s53 offen offset:1024 nt lds
    buffer_load_dwordx4 v193, s[24:27], s53 offen offset:2048 nt lds
    buffer_load_dwordx4 v193, s[24:27], s53 offen offset:3072 nt lds
    s_lshr_b32 s67, s2, 3
    s_lshl_b32 s67, s67, 1
    s_add_u32 s67, s67, s45
    s_lshl_b32 s67, s67, 11
    buffer_load_dwordx4 v[88:91], v193, s[20:23], s67 offen
    buffer_load_dwordx4 v[92:95], v193, s[20:23], s67 offen offset:1024
    s_add_u32 s36, s8, s3
    s_addc_u32 s37, s9, 0
    s_mov_b32 s38, s12
    s_mov_b32 s39, s13
    s_add_u32 s28, s14, s55
    s_addc_u32 s29, s15, 0
    s_mov_b32 s30, 0x4000
    s_mov_b32 s31, 0x20000
    s_load_dword s53, s[36:37], 0
    s_mov_b32 s34, 0
    s_mov_b32 s35, 0x20000
    s_mov_b32 s68, s32
    s_mov_b32 s69, s33
    s_mov_b32 s70, 256
    s_mov_b32 s71, 0x20000
    s_mov_b32 s64, 144
    s_mov_b32 s66, 0xd0
    s_mov_b32 s65, 0
    s_mov_b32 s56, 0
    s_cmp_lt_u32 s2, 8
    s_cselect_b32 s57, s45, 1
    v_mov_b32 v54, 0
    v_mov_b32 v52, 0
    v_mov_b32 v53, 0
    v_lshlrev_b32 v55, 8, v12
    s_mov_b32 s40, 0x05040100
    s_mov_b32 s41, 0x07060302
    s_mov_b32 s60, 0x3db504f3
    s_mov_b32 s61, 0xffff0000
    s_mov_b32 s62, 0x3fb8aa3b
    v_lshl_add_u32 v6, v8, 13, v193
    v_xor_b32 v7, 0x2000, v6
    v_lshlrev_b32 v3, 12, v8
    v_lshl_add_u32 v3, v9, 8, v3
    v_lshl_add_u32 v3, v10, 6, v3
    v_add_u32 v3, 32768, v3
    v_lshlrev_b32 v4, 12, v8
    v_lshl_add_u32 v4, v10, 10, v4
    v_lshl_add_u32 v4, v9, 4, v4
    v_mov_b32 v50, 0
    v_mov_b32 v51, 0
    s_mov_b32 s46, 0
L_kouter:
    v_mov_b64 v[8:9], 0
    v_mov_b64 v[10:11], 0
    v_mov_b64 v[12:13], 0
    v_mov_b64 v[14:15], 0
    v_mov_b64 v[16:17], 0
    v_mov_b64 v[18:19], 0
    v_mov_b64 v[20:21], 0
    v_mov_b64 v[22:23], 0
    v_mov_b64 v[24:25], 0
    v_mov_b64 v[26:27], 0
    v_mov_b64 v[28:29], 0
    v_mov_b64 v[30:31], 0
    v_mov_b64 v[32:33], 0
    v_mov_b64 v[34:35], 0
    v_mov_b64 v[36:37], 0
    v_mov_b64 v[38:39], 0
    s_mov_b32 s42, 0
L_kloop:
    s_waitcnt vmcnt(9)
    v_perm_b32 v40, v124, v120, s40
    v_perm_b32 v41, v132, v128, s40
    v_perm_b32 v42, v140, v136, s40
    v_perm_b32 v43, v148, v144, s40
    v_perm_b32 v44, v124, v120, s41
    v_perm_b32 v45, v132, v128, s41
    v_perm_b32 v46, v140, v136, s41
    v_perm_b32 v47, v148, v144, s41
    v_mfma_f32_16x16x32_bf16 v[8:11], v[40:43], v[152:155], v[8:11]
    v_perm_b32 v40, v125, v121, s40
    v_perm_b32 v41, v133, v129, s40
    v_perm_b32 v42, v141, v137, s40
    v_perm_b32 v43, v149, v145, s40
    v_mfma_f32_16x16x32_bf16 v[12:15], v[44:47], v[152:155], v[12:15]
    v_perm_b32 v44, v125, v121, s41
    v_perm_b32 v45, v133, v129, s41
    v_perm_b32 v46, v141, v137, s41
    v_perm_b32 v47, v149, v145, s41
    v_mfma_f32_16x16x32_bf16 v[16:19], v[40:43], v[152:155], v[16:19]
    v_perm_b32 v40, v126, v122, s40
    v_perm_b32 v41, v134, v130, s40
    v_perm_b32 v42, v142, v138, s40
    v_perm_b32 v43, v150, v146, s40
    v_mfma_f32_16x16x32_bf16 v[20:23], v[44:47], v[152:155], v[20:23]
    v_perm_b32 v44, v126, v122, s41
    v_perm_b32 v45, v134, v130, s41
    v_perm_b32 v46, v142, v138, s41
    v_perm_b32 v47, v150, v146, s41
    v_mfma_f32_16x16x32_bf16 v[24:27], v[40:43], v[152:155], v[24:27]
    v_perm_b32 v40, v127, v123, s40
    v_perm_b32 v41, v135, v131, s40
    v_perm_b32 v42, v143, v139, s40
    v_perm_b32 v43, v151, v147, s40
    v_mfma_f32_16x16x32_bf16 v[28:31], v[44:47], v[152:155], v[28:31]
    v_perm_b32 v44, v127, v123, s41
    v_perm_b32 v45, v135, v131, s41
    v_perm_b32 v46, v143, v139, s41
    v_perm_b32 v47, v151, v147, s41
    v_mfma_f32_16x16x32_bf16 v[32:35], v[40:43], v[152:155], v[32:35]
    s_nop 1
    v_mfma_f32_16x16x32_bf16 v[36:39], v[44:47], v[152:155], v[36:39]
    buffer_load_dwordx4 v[120:123], v1, s[16:19], s43 offen nt
    buffer_load_dwordx4 v[124:127], v1, s[16:19], s43 offen offset:256 nt
    buffer_load_dwordx4 v[128:131], v1, s[16:19], s43 offen offset:512 nt
    s_waitcnt vmcnt(9)
L_cb1:
    buffer_load_dwordx4 v[132:135], v1, s[16:19], s43 offen offset:768 nt
    buffer_load_dwordx4 v[136:139], v1, s[16:19], s43 offen offset:1024 nt
    buffer_load_dwordx4 v[140:143], v1, s[16:19], s43 offen offset:1280 nt
    buffer_load_dwordx4 v[144:147], v1, s[16:19], s43 offen offset:1536 nt
    buffer_load_dwordx4 v[148:151], v1, s[16:19], s43 offen offset:1792 nt
    buffer_load_dwordx4 v[152:155], v2, s[20:23], s44 offen
    s_add_u32 s43, s43, 0x4000
    s_add_u32 s44, s44, 128
    s_and_b32 s44, s44, 0x1fff
    s_add_u32 s47, s47, 1
    s_waitcnt vmcnt(9)
    v_perm_b32 v40, v160, v156, s40
    v_perm_b32 v41, v168, v164, s40
    v_perm_b32 v42, v176, v172, s40
    v_perm_b32 v43, v184, v180, s40
    v_perm_b32 v44, v160, v156, s41
    v_perm_b32 v45, v168, v164, s41
    v_perm_b32 v46, v176, v172, s41
    v_perm_b32 v47, v184, v180, s41
    v_mfma_f32_16x16x32_bf16 v[8:11], v[40:43], v[188:191], v[8:11]
    v_perm_b32 v40, v161, v157, s40
    v_perm_b32 v41, v169, v165, s40
    v_perm_b32 v42, v177, v173, s40
    v_perm_b32 v43, v185, v181, s40
    v_mfma_f32_16x16x32_bf16 v[12:15], v[44:47], v[188:191], v[12:15]
    v_perm_b32 v44, v161, v157, s41
    v_perm_b32 v45, v169, v165, s41
    v_perm_b32 v46, v177, v173, s41
    v_perm_b32 v47, v185, v181, s41
    v_mfma_f32_16x16x32_bf16 v[16:19], v[40:43], v[188:191], v[16:19]
    v_perm_b32 v40, v162, v158, s40
    v_perm_b32 v41, v170, v166, s40
    v_perm_b32 v42, v178, v174, s40
    v_perm_b32 v43, v186, v182, s40
    v_mfma_f32_16x16x32_bf16 v[20:23], v[44:47], v[188:191], v[20:23]
    v_perm_b32 v44, v162, v158, s41
    v_perm_b32 v45, v170, v166, s41
    v_perm_b32 v46, v178, v174, s41
    v_perm_b32 v47, v186, v182, s41
    v_mfma_f32_16x16x32_bf16 v[24:27], v[40:43], v[188:191], v[24:27]
    v_perm_b32 v40, v163, v159, s40
    v_perm_b32 v41, v171, v167, s40
    v_perm_b32 v42, v179, v175, s40
    v_perm_b32 v43, v187, v183, s40
    v_mfma_f32_16x16x32_bf16 v[28:31], v[44:47], v[188:191], v[28:31]
    v_perm_b32 v44, v163, v159, s41
    v_perm_b32 v45, v171, v167, s41
    v_perm_b32 v46, v179, v175, s41
    v_perm_b32 v47, v187, v183, s41
    v_mfma_f32_16x16x32_bf16 v[32:35], v[40:43], v[188:191], v[32:35]
    s_nop 1
    v_mfma_f32_16x16x32_bf16 v[36:39], v[44:47], v[188:191], v[36:39]
    buffer_load_dwordx4 v[156:159], v1, s[16:19], s43 offen nt
    buffer_load_dwordx4 v[160:163], v1, s[16:19], s43 offen offset:256 nt
    buffer_load_dwordx4 v[164:167], v1, s[16:19], s43 offen offset:512 nt
    s_cmp_eq_u32 s42, 31
    s_cbranch_scc1 L_cb2
    s_waitcnt vmcnt(9)
L_cb2:
    buffer_load_dwordx4 v[168:171], v1, s[16:19], s43 offen offset:768 nt
    buffer_load_dwordx4 v[172:175], v1, s[16:19], s43 offen offset:1024 nt
    buffer_load_dwordx4 v[176:179], v1, s[16:19], s43 offen offset:1280 nt
    buffer_load_dwordx4 v[180:183], v1, s[16:19], s43 offen offset:1536 nt
    buffer_load_dwordx4 v[184:187], v1, s[16:19], s43 offen offset:1792 nt
    buffer_load_dwordx4 v[188:191], v2, s[20:23], s44 offen
    s_add_u32 s43, s43, 0x4000
    s_add_u32 s44, s44, 128
    s_and_b32 s44, s44, 0x1fff
    s_add_u32 s47, s47, 1
    s_cmp_eq_u32 s47, 128
    s_cselect_b64 s[16:17], s[36:37], s[16:17]
    s_cselect_b64 s[20:21], s[38:39], s[20:21]
    s_cselect_b32 s43, 0, s43
    s_add_u32 s42, s42, 1
    s_cmp_lt_u32 s42, 32
    s_cbranch_scc1 L_kloop
    s_nop 7
    ds_write_b128 v6, v[8:11] offset:0
    ds_write_b128 v6, v[12:15] offset:1024
    ds_write_b128 v6, v[16:19] offset:2048
    ds_write_b128 v6, v[20:23] offset:3072
    ds_write_b128 v6, v[24:27] offset:4096
    ds_write_b128 v6, v[28:31] offset:5120
    ds_write_b128 v6, v[32:35] offset:6144
    ds_write_b128 v6, v[36:39] offset:7168
    s_waitcnt lgkmcnt(0)
    s_barrier
    ds_read_b128 v[88:91], v7 offset:0
    ds_read_b128 v[92:95], v7 offset:1024
    ds_read_b128 v[96:99], v7 offset:2048
    ds_read_b128 v[100:103], v7 offset:3072
    ds_read_b128 v[104:107], v7 offset:4096
    ds_read_b128 v[108:111], v7 offset:5120
    ds_read_b128 v[112:115], v7 offset:6144
    ds_read_b128 v[116:119], v7 offset:7168
    ds_read_b128 v[72:75], v3 offset:0
    ds_read_b128 v[76:79], v3 offset:16
    ds_read_b128 v[80:83], v3 offset:32
    ds_read_b128 v[84:87], v3 offset:48
    s_waitcnt lgkmcnt(11)
    v_pk_add_f32 v[8:9], v[8:9], v[88:89]
    v_pk_add_f32 v[10:11], v[10:11], v[90:91]
    s_waitcnt lgkmcnt(10)
    v_pk_add_f32 v[12:13], v[12:13], v[92:93]
    v_pk_add_f32 v[14:15], v[14:15], v[94:95]
    s_waitcnt lgkmcnt(9)
    v_pk_add_f32 v[16:17], v[16:17], v[96:97]
    v_pk_add_f32 v[18:19], v[18:19], v[98:99]
    s_waitcnt lgkmcnt(8)
    v_pk_add_f32 v[20:21], v[20:21], v[100:101]
    v_pk_add_f32 v[22:23], v[22:23], v[102:103]
    s_waitcnt lgkmcnt(7)
    v_pk_add_f32 v[24:25], v[24:25], v[104:105]
    v_pk_add_f32 v[26:27], v[26:27], v[106:107]
    s_waitcnt lgkmcnt(6)
    v_pk_add_f32 v[28:29], v[28:29], v[108:109]
    v_pk_add_f32 v[30:31], v[30:31], v[110:111]
    s_waitcnt lgkmcnt(5)
    v_pk_add_f32 v[32:33], v[32:33], v[112:113]
    v_pk_add_f32 v[34:35], v[34:35], v[114:115]
    s_waitcnt lgkmcnt(4)
    v_pk_add_f32 v[36:37], v[36:37], v[116:117]
    v_pk_add_f32 v[38:39], v[38:39], v[118:119]
    v_cvt_pk_bf16_f32 v56, v8, v12
    v_cvt_pk_bf16_f32 v57, v16, v20
    v_cvt_pk_bf16_f32 v58, v24, v28
    v_cvt_pk_bf16_f32 v59, v32, v36
    v_cvt_pk_bf16_f32 v60, v9, v13
    v_cvt_pk_bf16_f32 v61, v17, v21
    v_cvt_pk_bf16_f32 v62, v25, v29
    v_cvt_pk_bf16_f32 v63, v33, v37
    v_cvt_pk_bf16_f32 v64, v10, v14
    v_cvt_pk_bf16_f32 v65, v18, v22
    v_cvt_pk_bf16_f32 v66, v26, v30
    v_cvt_pk_bf16_f32 v67, v34, v38
    v_cvt_pk_bf16_f32 v68, v11, v15
    v_cvt_pk_bf16_f32 v69, v19, v23
    v_cvt_pk_bf16_f32 v70, v27, v31
    v_cvt_pk_bf16_f32 v71, v35, v39
    s_waitcnt lgkmcnt(0)
    v_mfma_f32_16x16x32_bf16 v[40:43], v[56:59], v[72:75], 0
    v_mfma_f32_16x16x32_bf16 v[40:43], v[60:63], v[76:79], v[40:43]
    v_mfma_f32_16x16x32_bf16 v[40:43], v[64:67], v[80:83], v[40:43]
    v_mfma_f32_16x16x32_bf16 v[40:43], v[68:71], v[84:87], v[40:43]
    s_nop 7
    v_cvt_pk_bf16_f32 v44, v40, v41
    v_cvt_pk_bf16_f32 v45, v42, v43
    v_lshlrev_b32 v40, 16, v44
    v_and_b32 v41, s61, v44
    v_lshlrev_b32 v42, 16, v45
    v_and_b32 v43, s61, v45
    v_mul_f32 v40, s60, v40
    v_mul_f32 v41, s60, v41
    v_mul_f32 v42, s60, v42
    v_mul_f32 v43, s60, v43
    v_cvt_pk_bf16_f32 v44, v40, v41
    v_cvt_pk_bf16_f32 v45, v42, v43
    v_lshlrev_b32 v40, 16, v44
    v_and_b32 v41, s61, v44
    v_lshlrev_b32 v42, 16, v45
    v_and_b32 v43, s61, v45
    v_max_f32 v44, v40, v41
    v_max3_f32 v44, v44, v42, v43
    v_mov_b32 v45, v44
    s_nop 1
    v_permlane16_swap_b32 v44, v45
    v_max_f32 v44, v44, v45
    v_mov_b32 v45, v44
    s_nop 1
    v_permlane32_swap_b32 v44, v45
    v_max_f32 v44, v44, v45
    v_sub_f32 v40, v40, v44
    v_sub_f32 v41, v41, v44
    v_sub_f32 v42, v42, v44
    v_sub_f32 v43, v43, v44
    v_mul_f32 v40, s62, v40
    v_mul_f32 v41, s62, v41
    v_mul_f32 v42, s62, v42
    v_mul_f32 v43, s62, v43
    v_exp_f32 v40, v40
    v_exp_f32 v41, v41
    v_exp_f32 v42, v42
    v_exp_f32 v43, v43
    s_nop 0
    v_add_f32 v44, v40, v41
    v_add_f32 v45, v42, v43
    v_add_f32 v44, v44, v45
    v_mov_b32 v45, v44
    s_nop 1
    v_permlane16_swap_b32 v44, v45
    v_add_f32 v44, v44, v45
    v_mov_b32 v45, v44
    s_nop 1
    v_permlane32_swap_b32 v44, v45
    v_add_f32 v44, v44, v45
    v_rcp_f32 v44, v44
    s_nop 0
    v_mul_f32 v40, v40, v44
    v_mul_f32 v41, v41, v44
    v_mul_f32 v42, v42, v44
    v_mul_f32 v43, v43, v44
    v_mov_b32 v48, v50
    v_mov_b32 v49, v51
    v_cvt_pk_bf16_f32 v50, v40, v41
    v_cvt_pk_bf16_f32 v51, v42, v43
    v_xor_b32 v6, 16384, v6
    v_xor_b32 v7, 16384, v7
    s_cmp_lg_u32 s46, 0
    s_cbranch_scc1 L_kdone
    s_mov_b32 s24, s38
    s_mov_b32 s25, s39
    s_mov_b32 s26, 0x20000
    buffer_load_dwordx4 v[88:91], v193, s[24:27], s67 offen
    buffer_load_dwordx4 v[92:95], v193, s[24:27], s67 offen offset:1024
    v_add_u32 v3, 0x2000, v3
    s_mov_b32 s46, 1
    s_branch L_kouter
L_kdone:
    s_mov_b32 s46, 0
    buffer_load_dword v52, v55, s[32:35], s65 offen sc1
    buffer_load_dword v53, v55, s[32:35], s65 offen sc1
L_vouter:
    v_mov_b64 v[8:9], 0
    v_mov_b64 v[10:11], 0
    v_mov_b64 v[12:13], 0
    v_mov_b64 v[14:15], 0
    v_mov_b64 v[16:17], 0
    v_mov_b64 v[18:19], 0
    v_mov_b64 v[20:21], 0
    v_mov_b64 v[22:23], 0
    v_mov_b64 v[24:25], 0
    v_mov_b64 v[26:27], 0
    v_mov_b64 v[28:29], 0
    v_mov_b64 v[30:31], 0
    v_mov_b64 v[32:33], 0
    v_mov_b64 v[34:35], 0
    v_mov_b64 v[36:37], 0
    v_mov_b64 v[38:39], 0
    s_mov_b32 s42, 0
L_vloop:
    s_waitcnt vmcnt(11)
    v_perm_b32 v40, v124, v120, s40
    v_perm_b32 v41, v132, v128, s40
    v_perm_b32 v42, v140, v136, s40
    v_perm_b32 v43, v148, v144, s40
    v_perm_b32 v44, v124, v120, s41
    v_perm_b32 v45, v132, v128, s41
    v_perm_b32 v46, v140, v136, s41
    v_perm_b32 v47, v148, v144, s41
    v_mfma_f32_16x16x32_bf16 v[8:11], v[152:155], v[40:43], v[8:11]
    v_perm_b32 v40, v125, v121, s40
    v_perm_b32 v41, v133, v129, s40
    v_perm_b32 v42, v141, v137, s40
    v_perm_b32 v43, v149, v145, s40
    v_mfma_f32_16x16x32_bf16 v[12:15], v[152:155], v[44:47], v[12:15]
    v_perm_b32 v44, v125, v121, s41
    v_perm_b32 v45, v133, v129, s41
    v_perm_b32 v46, v141, v137, s41
    v_perm_b32 v47, v149, v145, s41
    v_mfma_f32_16x16x32_bf16 v[16:19], v[152:155], v[40:43], v[16:19]
    v_perm_b32 v40, v126, v122, s40
    v_perm_b32 v41, v134, v130, s40
    v_perm_b32 v42, v142, v138, s40
    v_perm_b32 v43, v150, v146, s40
    v_mfma_f32_16x16x32_bf16 v[20:23], v[152:155], v[44:47], v[20:23]
    v_perm_b32 v44, v126, v122, s41
    v_perm_b32 v45, v134, v130, s41
    v_perm_b32 v46, v142, v138, s41
    v_perm_b32 v47, v150, v146, s41
    v_mfma_f32_16x16x32_bf16 v[24:27], v[152:155], v[40:43], v[24:27]
    v_perm_b32 v40, v127, v123, s40
    v_perm_b32 v41, v135, v131, s40
    v_perm_b32 v42, v143, v139, s40
    v_perm_b32 v43, v151, v147, s40
    v_mfma_f32_16x16x32_bf16 v[28:31], v[152:155], v[44:47], v[28:31]
    v_perm_b32 v44, v127, v123, s41
    v_perm_b32 v45, v135, v131, s41
    v_perm_b32 v46, v143, v139, s41
    v_perm_b32 v47, v151, v147, s41
    v_mfma_f32_16x16x32_bf16 v[32:35], v[152:155], v[40:43], v[32:35]
    s_nop 1
    v_mfma_f32_16x16x32_bf16 v[36:39], v[152:155], v[44:47], v[36:39]
    s_cmp_eq_u32 s47, 256
    s_cbranch_scc1 L_stub3
    buffer_load_dwordx4 v[120:123], v1, s[16:19], s43 offen nt
    buffer_load_dwordx4 v[124:127], v1, s[16:19], s43 offen offset:256 nt
    buffer_load_dwordx4 v[128:131], v1, s[16:19], s43 offen offset:512 nt
    s_cmp_lg_u32 s56, 0
    s_cbranch_scc1 L_cs6
    s_waitcnt vmcnt(10)
L_cb5:
    buffer_load_dwordx4 v[132:135], v1, s[16:19], s43 offen offset:768 nt
    buffer_load_dwordx4 v[136:139], v1, s[16:19], s43 offen offset:1024 nt
    buffer_load_dwordx4 v[140:143], v1, s[16:19], s43 offen offset:1280 nt
    buffer_load_dwordx4 v[144:147], v1, s[16:19], s43 offen offset:1536 nt
    buffer_load_dwordx4 v[148:151], v1, s[16:19], s43 offen offset:1792 nt
    buffer_load_dwordx4 v[152:155], v2, s[20:23], s44 offen
    v_add_u32 v54, v54, v52
    buffer_load_dword v52, v55, s[32:35], s65 offen sc1
    s_add_u32 s43, s43, 0x4000
    s_add_u32 s44, s44, 128
    s_and_b32 s44, s44, 0x1fff
    s_add_u32 s47, s47, 1
L_back4:
    s_waitcnt vmcnt(11)
    v_perm_b32 v40, v160, v156, s40
    v_perm_b32 v41, v168, v164, s40
    v_perm_b32 v42, v176, v172, s40
    v_perm_b32 v43, v184, v180, s40
    v_perm_b32 v44, v160, v156, s41
    v_perm_b32 v45, v168, v164, s41
    v_perm_b32 v46, v176, v172, s41
    v_perm_b32 v47, v184, v180, s41
    v_mfma_f32_16x16x32_bf16 v[8:11], v[188:191], v[40:43], v[8:11]
    v_perm_b32 v40, v161, v157, s40
    v_perm_b32 v41, v169, v165, s40
    v_perm_b32 v42, v177, v173, s40
    v_perm_b32 v43, v185, v181, s40
    v_mfma_f32_16x16x32_bf16 v[12:15], v[188:191], v[44:47], v[12:15]
    v_perm_b32 v44, v161, v157, s41
    v_perm_b32 v45, v169, v165, s41
    v_perm_b32 v46, v177, v173, s41
    v_perm_b32 v47, v185, v181, s41
    v_mfma_f32_16x16x32_bf16 v[16:19], v[188:191], v[40:43], v[16:19]
    v_perm_b32 v40, v162, v158, s40
    v_perm_b32 v41, v170, v166, s40
    v_perm_b32 v42, v178, v174, s40
    v_perm_b32 v43, v186, v182, s40
    v_mfma_f32_16x16x32_bf16 v[20:23], v[188:191], v[44:47], v[20:23]
    v_perm_b32 v44, v162, v158, s41
    v_perm_b32 v45, v170, v166, s41
    v_perm_b32 v46, v178, v174, s41
    v_perm_b32 v47, v186, v182, s41
    v_mfma_f32_16x16x32_bf16 v[24:27], v[188:191], v[40:43], v[24:27]
    v_perm_b32 v40, v163, v159, s40
    v_perm_b32 v41, v171, v167, s40
    v_perm_b32 v42, v179, v175, s40
    v_perm_b32 v43, v187, v183, s40
    v_mfma_f32_16x16x32_bf16 v[28:31], v[188:191], v[44:47], v[28:31]
    v_perm_b32 v44, v163, v159, s41
    v_perm_b32 v45, v171, v167, s41
    v_perm_b32 v46, v179, v175, s41
    v_perm_b32 v47, v187, v183, s41
    v_mfma_f32_16x16x32_bf16 v[32:35], v[188:191], v[40:43], v[32:35]
    s_nop 1
    v_mfma_f32_16x16x32_bf16 v[36:39], v[188:191], v[44:47], v[36:39]
    s_cmp_eq_u32 s47, 256
    s_cbranch_scc1 L_back9
    buffer_load_dwordx4 v[156:159], v1, s[16:19], s43 offen nt
    buffer_load_dwordx4 v[160:163], v1, s[16:19], s43 offen offset:256 nt
    buffer_load_dwordx4 v[164:167], v1, s[16:19], s43 offen offset:512 nt
    s_cmp_eq_u32 s42, 31
    s_cbranch_scc1 L_cb10
    s_cmp_lg_u32 s56, 0
    s_cbranch_scc1 L_cs11
    s_waitcnt vmcnt(10)
L_cb10:
    buffer_load_dwordx4 v[168:171], v1, s[16:19], s43 offen offset:768 nt
    buffer_load_dwordx4 v[172:175], v1, s[16:19], s43 offen offset:1024 nt
    buffer_load_dwordx4 v[176:179], v1, s[16:19], s43 offen offset:1280 nt
    buffer_load_dwordx4 v[180:183], v1, s[16:19], s43 offen offset:1536 nt
    buffer_load_dwordx4 v[184:187], v1, s[16:19], s43 offen offset:1792 nt
    buffer_load_dwordx4 v[188:191], v2, s[20:23], s44 offen
    v_add_u32 v54, v54, v53
    buffer_load_dword v53, v55, s[32:35], s65 offen sc1
    s_add_u32 s43, s43, 0x4000
    s_add_u32 s44, s44, 128
    s_and_b32 s44, s44, 0x1fff
    s_add_u32 s47, s47, 1
    s_sub_u32 s52, s47, s64
    s_cmp_lt_u32 s52, 16
    s_cselect_b32 s34, 128, 0
    s_cmp_eq_u32 s57, 0
    s_cbranch_scc1 L_rp13
L_rb14:
    s_cmp_eq_u32 s52, 18
    s_cbranch_scc1 L_dc16
L_db17:
L_back9:
    s_add_u32 s42, s42, 1
    s_cmp_lt_u32 s42, 32
    s_cbranch_scc1 L_vloop
    s_branch L_after18
L_cs6:
    s_cmp_lt_i32 s56, 0
    s_cbranch_scc1 L_sl7
    s_sub_u32 s56, s56, 1
    s_branch L_cb5
L_sl7:
    s_add_u32 s56, s56, 1
    s_waitcnt vmcnt(8)
    s_branch L_cb5
L_stub3:
    s_waitcnt vmcnt(0)
    s_branch L_back4
L_cs11:
    s_cmp_lt_i32 s56, 0
    s_cbranch_scc1 L_sl12
    s_sub_u32 s56, s56, 1
    s_branch L_cb10
L_sl12:
    s_add_u32 s56, s56, 1
    s_waitcnt vmcnt(8)
    s_branch L_cb10
L_dc16:
    v_readfirstlane_b32 s53, v54
    v_mov_b32 v54, 0
    s_add_u32 s65, s65, 4
    s_sub_i32 s53, s53, 7
    s_mul_i32 s54, s53, 10
    s_mul_i32 s56, s53, 4
    s_cmp_gt_i32 s53, 0
    s_cselect_b32 s56, s54, s56
    s_and_b32 s64, s66, 0xff
    s_cselect_b32 s64, s64, 0x10000
    s_lshr_b32 s66, s66, 8
    s_branch L_db17
L_rp13:
    s_cmp_eq_u32 s52, 8
    s_cbranch_scc1 L_rc15
    s_cmp_lg_i32 s52, -12
    s_cbranch_scc1 L_rb14
    v_mov_b32 v192, 1
    s_mov_b64 exec, 1
    buffer_atomic_add v192, off, s[68:71], s65 offset:128 sc0 sc1
    s_mov_b64 exec, -1
    s_branch L_rb14
L_rc15:
    v_readfirstlane_b32 s53, v192
    v_mov_b32 v194, 1
    s_cmp_lg_u32 s53, 3
    s_cbranch_scc1 L_rb14
    s_mov_b64 exec, 1
    buffer_store_dword v194, off, s[68:71], s65 sc1
    s_mov_b64 exec, -1
    s_branch L_rb14
L_after18:
    s_cmp_eq_u32 s46, 0
    s_cbranch_scc1 L_noest
    buffer_store_dwordx4 v[72:75], v4, s[28:31], 0 offen offset:0 nt
    buffer_store_dwordx4 v[76:79], v4, s[28:31], 0 offen offset:256 nt
    buffer_store_dwordx4 v[80:83], v4, s[28:31], 0 offen offset:512 nt
    buffer_store_dwordx4 v[84:87], v4, s[28:31], 0 offen offset:768 nt
L_noest:
    s_nop 7
    ds_write_b128 v6, v[8:11] offset:0
    ds_write_b128 v6, v[12:15] offset:1024
    ds_write_b128 v6, v[16:19] offset:2048
    ds_write_b128 v6, v[20:23] offset:3072
    ds_write_b128 v6, v[24:27] offset:4096
    ds_write_b128 v6, v[28:31] offset:5120
    ds_write_b128 v6, v[32:35] offset:6144
    ds_write_b128 v6, v[36:39] offset:7168
    s_waitcnt lgkmcnt(0)
    s_barrier
    ds_read_b128 v[88:91], v7 offset:0
    ds_read_b128 v[92:95], v7 offset:1024
    ds_read_b128 v[96:99], v7 offset:2048
    ds_read_b128 v[100:103], v7 offset:3072
    ds_read_b128 v[104:107], v7 offset:4096
    ds_read_b128 v[108:111], v7 offset:5120
    ds_read_b128 v[112:115], v7 offset:6144
    ds_read_b128 v[116:119], v7 offset:7168
    s_waitcnt lgkmcnt(7)
    v_pk_add_f32 v[8:9], v[8:9], v[88:89]
    v_pk_add_f32 v[10:11], v[10:11], v[90:91]
    s_waitcnt lgkmcnt(6)
    v_pk_add_f32 v[12:13], v[12:13], v[92:93]
    v_pk_add_f32 v[14:15], v[14:15], v[94:95]
    s_waitcnt lgkmcnt(5)
    v_pk_add_f32 v[16:17], v[16:17], v[96:97]
    v_pk_add_f32 v[18:19], v[18:19], v[98:99]
    s_waitcnt lgkmcnt(4)
    v_pk_add_f32 v[20:21], v[20:21], v[100:101]
    v_pk_add_f32 v[22:23], v[22:23], v[102:103]
    s_waitcnt lgkmcnt(3)
    v_pk_add_f32 v[24:25], v[24:25], v[104:105]
    v_pk_add_f32 v[26:27], v[26:27], v[106:107]
    s_waitcnt lgkmcnt(2)
    v_pk_add_f32 v[28:29], v[28:29], v[108:109]
    v_pk_add_f32 v[30:31], v[30:31], v[110:111]
    s_waitcnt lgkmcnt(1)
    v_pk_add_f32 v[32:33], v[32:33], v[112:113]
    v_pk_add_f32 v[34:35], v[34:35], v[114:115]
    s_waitcnt lgkmcnt(0)
    v_pk_add_f32 v[36:37], v[36:37], v[116:117]
    v_pk_add_f32 v[38:39], v[38:39], v[118:119]
    v_cvt_pk_bf16_f32 v56, v8, v9
    v_cvt_pk_bf16_f32 v57, v10, v11
    v_cvt_pk_bf16_f32 v58, v12, v13
    v_cvt_pk_bf16_f32 v59, v14, v15
    v_cvt_pk_bf16_f32 v60, v16, v17
    v_cvt_pk_bf16_f32 v61, v18, v19
    v_cvt_pk_bf16_f32 v62, v20, v21
    v_cvt_pk_bf16_f32 v63, v22, v23
    v_cvt_pk_bf16_f32 v64, v24, v25
    v_cvt_pk_bf16_f32 v65, v26, v27
    v_cvt_pk_bf16_f32 v66, v28, v29
    v_cvt_pk_bf16_f32 v67, v30, v31
    v_cvt_pk_bf16_f32 v68, v32, v33
    v_cvt_pk_bf16_f32 v69, v34, v35
    v_cvt_pk_bf16_f32 v70, v36, v37
    v_cvt_pk_bf16_f32 v71, v38, v39
    s_nop 1
    v_mfma_f32_16x16x16_bf16 v[88:91], v[48:49], v[56:57], 0
    v_mfma_f32_16x16x16_bf16 v[92:95], v[48:49], v[58:59], 0
    v_mfma_f32_16x16x16_bf16 v[96:99], v[48:49], v[60:61], 0
    v_mfma_f32_16x16x16_bf16 v[100:103], v[48:49], v[62:63], 0
    v_mfma_f32_16x16x16_bf16 v[104:107], v[48:49], v[64:65], 0
    v_mfma_f32_16x16x16_bf16 v[108:111], v[48:49], v[66:67], 0
    v_mfma_f32_16x16x16_bf16 v[112:115], v[48:49], v[68:69], 0
    v_mfma_f32_16x16x16_bf16 v[116:119], v[48:49], v[70:71], 0
    s_nop 7
    s_cmp_lg_u32 s46, 0
    s_cbranch_scc1 L_vlast
    v_cvt_pk_bf16_f32 v72, v88, v92
    v_cvt_pk_bf16_f32 v73, v96, v100
    v_cvt_pk_bf16_f32 v74, v104, v108
    v_cvt_pk_bf16_f32 v75, v112, v116
    v_cvt_pk_bf16_f32 v76, v89, v93
    v_cvt_pk_bf16_f32 v77, v97, v101
    v_cvt_pk_bf16_f32 v78, v105, v109
    v_cvt_pk_bf16_f32 v79, v113, v117
    v_cvt_pk_bf16_f32 v80, v90, v94
    v_cvt_pk_bf16_f32 v81, v98, v102
    v_cvt_pk_bf16_f32 v82, v106, v110
    v_cvt_pk_bf16_f32 v83, v114, v118
    v_cvt_pk_bf16_f32 v84, v91, v95
    v_cvt_pk_bf16_f32 v85, v99, v103
    v_cvt_pk_bf16_f32 v86, v107, v111
    v_cvt_pk_bf16_f32 v87, v115, v119
    v_mov_b32 v48, v50
    v_mov_b32 v49, v51
    v_xor_b32 v6, 16384, v6
    v_xor_b32 v7, 16384, v7
    s_mov_b32 s46, 1
    s_branch L_vouter
L_vlast:
    s_movk_i32 s49, 0x2000
    v_cvt_pk_bf16_f32 v8, v88, v92
    v_cvt_pk_bf16_f32 v9, v96, v100
    v_cvt_pk_bf16_f32 v10, v104, v108
    v_cvt_pk_bf16_f32 v11, v112, v116
    buffer_store_dwordx4 v[8:11], v4, s[28:31], s49 offen offset:0 nt
    v_cvt_pk_bf16_f32 v12, v89, v93
    v_cvt_pk_bf16_f32 v13, v97, v101
    v_cvt_pk_bf16_f32 v14, v105, v109
    v_cvt_pk_bf16_f32 v15, v113, v117
    buffer_store_dwordx4 v[12:15], v4, s[28:31], s49 offen offset:256 nt
    v_cvt_pk_bf16_f32 v16, v90, v94
    v_cvt_pk_bf16_f32 v17, v98, v102
    v_cvt_pk_bf16_f32 v18, v106, v110
    v_cvt_pk_bf16_f32 v19, v114, v118
    buffer_store_dwordx4 v[16:19], v4, s[28:31], s49 offen offset:512 nt
    v_cvt_pk_bf16_f32 v20, v91, v95
    v_cvt_pk_bf16_f32 v21, v99, v103
    v_cvt_pk_bf16_f32 v22, v107, v111
    v_cvt_pk_bf16_f32 v23, v115, v119
    buffer_store_dwordx4 v[20:23], v4, s[28:31], s49 offen offset:768 nt
L_end:
    s_endpgm
.section .rodata,"a"
.p2align 6
.amdhsa_kernel standalone__low_rank_proj_linformer__sampling_kernel
  .amdhsa_next_free_vgpr 195
  .amdhsa_next_free_sgpr 72
  .amdhsa_accum_offset 196
  .amdhsa_group_segment_fixed_size 0
  .amdhsa_kernarg_size 64
  .amdhsa_user_sgpr_count 2
  .amdhsa_user_sgpr_kernarg_segment_ptr 1
  .amdhsa_system_sgpr_workgroup_id_x 1
  .amdhsa_float_denorm_mode_32 3
.end_amdhsa_kernel
```
